```python
import torch

def _softmax(x, axis=-1):
    return torch.softmax(x, dim=axis)
def _gelu(x):
    return torch.nn.functional.gelu(x, approximate="tanh")
def _silu(x):
    return torch.nn.functional.silu(x)
def _sigmoid(x):
    return torch.sigmoid(x)
def _layernorm(x, axis=-1, eps=1e-5):
    m = x.mean(dim=axis, keepdim=True)
    v = x.var(dim=axis, keepdim=True, unbiased=False)
    return (x - m) / torch.sqrt(v + eps)
def _scatter_add(tgt, idx, src, axis=0):
    return tgt.clone().index_add_(axis, idx, src)
def _segment_sum(src, seg, n):
    out = torch.zeros((n,) + src.shape[1:], dtype=src.dtype)
    return out.index_add_(0, seg, src)
def _pad(x, pw):
    flat = tuple(v for pair in reversed(pw) for v in pair)
    return torch.nn.functional.pad(x, flat)

kernel_name = 'standalone__gqa_block_cached__sampling'

def setup_inputs():

    _w = (lambda a: (lambda t: t.to(torch.bfloat16) if t.is_floating_point() else t)(torch.as_tensor(a)))
    B, Sq, D = 8, 4, 512
    Hq, Hkv, Sk, Dh = 32, 8, 2048, 128
    assert Hq % Hkv == 0, (Hq, Hkv)
    return {
        "x": _w((lambda *s: torch.randn(*s, dtype=torch.bfloat16) * 0.8)(B, Sq, D)),
        "k_cache": _w((lambda *s: torch.randn(*s, dtype=torch.bfloat16) * 0.8)(B, Hkv, Sk, Dh)),
        "v_cache": _w((lambda *s: torch.randn(*s, dtype=torch.bfloat16) * 0.05)(B, Hkv, Sk, Dh)),
        "wq": _w((lambda *s: torch.randn(*s, dtype=torch.bfloat16) * 0.8)(D, Hq * Dh) * (D ** -0.5)),
        "wo": _w((lambda *s: torch.randn(*s, dtype=torch.bfloat16) * 0.05)(Hq * Dh, D) * ((Hq * Dh) ** -0.5)),
    }

def reference(x, k_cache, v_cache, wq, wo):
    B, Sq, D = x.shape
    Hq, Dh = 32, 128
    Hkv = k_cache.shape[1]
    rep = Hq // Hkv
    q = (lambda x, *d: x.permute(*d))((x @ wq).reshape(B, Sq, Hq, Dh), 0, 2, 1, 3)
    k = (lambda x, n, axis: torch.repeat_interleave(x, n, dim=axis))(k_cache, rep, axis=1)
    v = (lambda x, n, axis: torch.repeat_interleave(x, n, dim=axis))(v_cache, rep, axis=1)
    scores = torch.einsum("bhqd,bhkd->bhqk", q, k) * (Dh ** -0.5)
    p = _softmax(scores, axis=-1)
    o = torch.einsum("bhqk,bhkd->bhqd", p, v)
    return (lambda x, *d: x.permute(*d))(o, 0, 2, 1, 3).reshape(B, Sq, Hq * Dh) @ wo
```

```asm
; @launch grid=(256,1,1) block=(512,1,1) lds=163840
.amdgcn_target "amdgcn-amd-amdhsa--gfx950"
.text
.globl standalone__gqa_block_cached__sampling_kernel
.p2align 8
.type standalone__gqa_block_cached__sampling_kernel,@function
standalone__gqa_block_cached__sampling_kernel:
  s_cmp_ge_u32 s2, 256
  s_cbranch_scc1 L_end
  s_load_dwordx16 s[4:19], s[0:1], 0
  v_lshrrev_b32 v4, 6, v0
  v_and_b32 v1, 63, v0
  v_readfirstlane_b32 s3, v4
  v_and_b32 v2, 15, v0
  v_lshrrev_b32 v3, 4, v1
  v_lshlrev_b32 v34, 4, v1
  v_mov_b32 v45, 0
  s_and_b32 s52, s2, 7
  s_lshr_b32 s53, s2, 3
  s_lshr_b32 s54, s53, 2
  s_and_b32 s55, s53, 3
  s_lshl_b32 s56, s3, 14
  v_lshrrev_b32 v9, 3, v1
  v_and_b32 v10, 1, v3
  v_lshlrev_b32 v10, 1, v10
  v_and_b32 v11, 7, v1
  v_xor_b32 v10, v10, v11
  v_xor_b32 v11, 4, v10
  v_lshlrev_b32 v4, 13, v9
  v_lshl_add_u32 v5, v11, 4, v4
  v_add_u32 v5, 0x10000, v5
  v_lshl_add_u32 v4, v10, 4, v4
  v_lshlrev_b32 v32, 10, v9
  v_lshl_add_u32 v33, v11, 4, v32
  v_add_u32 v33, 0x2000, v33
  v_lshl_add_u32 v32, v10, 4, v32
  s_and_b32 s63, s3, 3
  s_lshl_b32 s63, s63, 2
  v_xor_b32 v7, v2, v3
  v_xor_b32 v6, s63, v7
  v_lshlrev_b32 v6, 4, v6
  v_lshl_add_u32 v6, v3, 10, v6
  s_lshr_b32 s64, s53, 3
  s_lshl_b32 s61, s64, 20
  s_lshl_b32 s62, s3, 17
  s_add_u32 s61, s61, s62
  s_lshl_b32 s62, s52, 10
  s_add_u32 s61, s61, s62
  s_and_b32 s62, s53, 7
  s_lshl_b32 s62, s62, 7
  s_add_u32 s61, s61, s62
  s_lshl_b32 s62, s3, 12
  s_lshl_b32 s64, s64, 8
  s_add_u32 s62, s62, s64
  s_lshl_b32 s64, s3, 11
  s_add_u32 s64, s64, 131072
  s_lshr_b32 s65, s3, 2
  s_lshl_b32 s65, s65, 14
  s_lshl_b32 s63, s63, 8
  s_add_u32 s63, s63, s65
  s_add_u32 s63, s63, 28672
  s_waitcnt lgkmcnt(0)
  s_mov_b32 s32, s10
  s_mov_b32 s33, s11
  s_mov_b32 s34, 0x400000
  s_mov_b32 s35, 0x20000
  s_mov_b32 s20, s4
  s_mov_b32 s21, s5
  s_mov_b32 s22, 0x8000
  s_mov_b32 s23, 0x20000
  s_mov_b32 m0, s64
  s_nop 0
  buffer_load_dwordx4 v4, s[32:35], s61 offen nt lds
  s_add_u32 m0, s64, 1024
  s_nop 0
  buffer_load_dwordx4 v5, s[32:35], s61 offen nt lds
  s_mov_b32 m0, s63
  s_nop 0
  buffer_load_dwordx4 v6, s[20:23], s62 offen lds
  s_barrier
  s_mov_b32 s24, s6
  s_mov_b32 s25, s7
  s_mov_b32 s26, 0x2000000
  s_mov_b32 s27, 0x20000
  s_mov_b32 s48, s18
  s_mov_b32 s49, s19
  s_mov_b32 s50, 0x10000000
  s_mov_b32 s51, 0x20000
  s_mov_b32 s44, s16
  s_mov_b32 s45, s17
  s_mov_b32 s46, 0x100
  s_mov_b32 s47, 0x20000
  s_lshl_b32 s61, s53, 3
  s_or_b32 s61, s61, s3
  s_cmp_eq_u32 s61, 1
  s_cbranch_scc0 L_nononce
  s_memrealtime s[70:71]
  v_mov_b32 v250, 0
  v_mov_b32 v251, 0
  s_waitcnt lgkmcnt(0)
  s_or_b32 s70, s70, 1
  s_and_b32 s71, s71, 0xfffffff
  v_mov_b32 v248, s70
  v_mov_b32 v249, s71
  s_mov_b64 exec, 1
  buffer_atomic_cmpswap_x2 v[248:251], v45, s[44:47], 0 offen sc1
  s_mov_b64 exec, -1
L_nononce:
  s_lshl_b32 s61, s54, 3
  s_add_u32 s61, s61, s52
  s_lshl_b32 s61, s61, 19
  s_lshl_b32 s62, s55, 17
  s_add_u32 s61, s61, s62
  s_add_u32 s61, s61, s56
  s_mul_i32 s62, s2, 0
  s_mul_i32 s63, s3, 1
  s_add_u32 s62, s62, s63
  s_mul_i32 s63, s53, 1
  s_add_u32 s62, s62, s63
  s_add_u32 s57, s62, 0
  s_and_b32 s57, s57, 3
  s_lshl_b32 s57, s57, 12
  s_add_u32 s57, s57, s61
  s_add_u32 s58, s62, 1
  s_and_b32 s58, s58, 3
  s_lshl_b32 s58, s58, 12
  s_add_u32 s58, s58, s61
  s_add_u32 s59, s62, 2
  s_and_b32 s59, s59, 3
  s_lshl_b32 s59, s59, 12
  s_add_u32 s59, s59, s61
  s_add_u32 s60, s62, 3
  s_and_b32 s60, s60, 3
  s_lshl_b32 s60, s60, 12
  s_add_u32 s60, s60, s61
  v_lshlrev_b32 v8, 8, v3
  v_xor_b32 v12, 0, v7
  v_lshl_add_u32 v12, v12, 4, v8
  v_xor_b32 v13, 4, v7
  v_lshl_add_u32 v13, v13, 4, v8
  v_xor_b32 v14, 8, v7
  v_lshl_add_u32 v14, v14, 4, v8
  v_xor_b32 v15, 12, v7
  v_lshl_add_u32 v15, v15, 4, v8
  s_add_u32 m0, s56, 0
  s_nop 0
  buffer_load_dwordx4 v12, s[24:27], s57 offen offset:0 nt lds
  s_add_u32 m0, s56, 0
  s_nop 0
  buffer_load_dwordx4 v13, s[24:27], s57 offen offset:1024 nt lds
  v_and_b32 v4, 3, v2
  v_lshrrev_b32 v5, 2, v2
  v_lshlrev_b32 v10, 8, v2
  v_xor_b32 v18, 0, v7
  v_lshl_add_u32 v18, v18, 4, v10
  v_xor_b32 v19, 4, v7
  v_lshl_add_u32 v19, v19, 4, v10
  v_xor_b32 v20, 8, v7
  v_lshl_add_u32 v20, v20, 4, v10
  v_xor_b32 v21, 12, v7
  v_lshl_add_u32 v21, v21, 4, v10
  s_lshr_b32 s63, s3, 2
  s_lshl_b32 s64, s63, 14
  s_add_u32 s64, s64, 28672
  v_add_u32 v220, s64, v18
  v_add_u32 v221, s64, v19
  v_add_u32 v222, s64, v20
  v_add_u32 v223, s64, v21
  v_lshl_add_u32 v29, v3, 3, v5
  v_lshlrev_b32 v29, 7, v29
  v_and_b32 v11, 1, v2
  v_lshl_add_u32 v29, v11, 3, v29
  v_add_u32 v29, 131072, v29
  v_lshrrev_b32 v28, 1, v5
  v_and_b32 v11, 1, v3
  v_lshl_add_u32 v28, v11, 1, v28
  v_lshlrev_b32 v28, 1, v28
  v_bfe_u32 v11, v2, 1, 1
  v_xor_b32 v28, v28, v11
  s_and_b32 s61, s3, 3
  s_lshl_b32 s62, s61, 1
  v_xor_b32 v6, s62, v28
  v_lshl_add_u32 v6, v6, 4, v29
  v_lshlrev_b32 v9, 15, v5
  v_lshl_add_u32 v9, v4, 9, v9
  v_lshl_add_u32 v9, v3, 4, v9
  s_lshl_b32 s33, s52, 18
  s_lshl_b32 s62, s63, 17
  s_add_u32 s33, s33, s62
  s_lshr_b32 s62, s53, 3
  s_lshl_b32 s62, s62, 13
  s_add_u32 s33, s33, s62
  s_bfe_u32 s62, s53, 0x20001
  s_lshl_b32 s62, s62, 11
  s_add_u32 s33, s33, s62
  s_and_b32 s62, s53, 1
  s_lshl_b32 s62, s62, 8
  s_add_u32 s33, s33, s62
  s_lshl_b32 s62, s61, 6
  s_add_u32 s33, s33, s62
  s_waitcnt vmcnt(2)
  buffer_load_dwordx2 v[50:51], v45, s[44:47], 0 offen sc1
  s_add_u32 m0, s56, 0
  s_nop 0
  buffer_load_dwordx4 v14, s[24:27], s57 offen offset:2048 nt lds
  s_add_u32 m0, s56, 0
  s_nop 0
  buffer_load_dwordx4 v15, s[24:27], s57 offen offset:3072 nt lds
  s_add_u32 m0, s56, 4096
  s_nop 0
  buffer_load_dwordx4 v12, s[24:27], s58 offen offset:0 nt lds
  s_barrier
  ds_read_b128 v[184:187], v220
  ds_read_b64_tr_b16 v[200:201], v6 offset:0
  ds_read_b64_tr_b16 v[202:203], v6 offset:512
  ds_read_b128 v[188:191], v221
  ds_read_b64_tr_b16 v[204:205], v6 offset:4096
  ds_read_b64_tr_b16 v[206:207], v6 offset:4608
  ds_read_b128 v[192:195], v222
  ds_read_b64_tr_b16 v[208:209], v6 offset:8192
  ds_read_b64_tr_b16 v[210:211], v6 offset:8704
  ds_read_b128 v[196:199], v223
  ds_read_b64_tr_b16 v[212:213], v6 offset:12288
  ds_read_b64_tr_b16 v[214:215], v6 offset:12800
  s_waitcnt lgkmcnt(9)
  v_mfma_f32_16x16x32_bf16 v[216:219], v[200:203], v[184:187], 0
  s_waitcnt lgkmcnt(6)
  v_mfma_f32_16x16x32_bf16 v[216:219], v[204:207], v[188:191], v[216:219]
  s_waitcnt lgkmcnt(3)
  v_mfma_f32_16x16x32_bf16 v[216:219], v[208:211], v[192:195], v[216:219]
  s_waitcnt lgkmcnt(0)
  v_mfma_f32_16x16x32_bf16 v[216:219], v[212:215], v[196:199], v[216:219]
  s_barrier
  s_waitcnt vmcnt(2)
  s_add_u32 m0, s56, 4096
  s_nop 0
  buffer_load_dwordx4 v13, s[24:27], s58 offen offset:1024 nt lds
  s_mov_b32 s65, 0
L_nonchk:
  v_cmp_eq_u32 vcc, 0, v50
  s_cbranch_vccz L_nonok
  buffer_load_dwordx2 v[50:51], v45, s[44:47], 0 offen sc1
  s_waitcnt vmcnt(0)
  s_add_u32 s65, s65, 1
  s_cmp_gt_u32 s65, 0x8000
  s_cbranch_scc1 L_nonok
  s_branch L_nonchk
L_nonok:
  s_getreg_b32 s64, hwreg(HW_REG_XCC_ID)
  s_and_b32 s64, s64, 15
  s_mul_i32 s64, s64, 0x9e3779b1
  v_add_u32 v46, s64, v50
  v_mov_b32 v6, 0xff
  v_lshrrev_b32 v10, 8, v46
  v_lshrrev_b32 v11, 16, v46
  v_lshrrev_b32 v52, 24, v46
  v_readfirstlane_b32 s7, v50
  v_readfirstlane_b32 s10, v51
  s_nop 1
  v_bfi_b32 v216, v6, v46, v216
  v_bfi_b32 v217, v6, v10, v217
  v_bfi_b32 v218, v6, v11, v218
  v_bfi_b32 v219, v6, v52, v219
  buffer_store_dwordx4 v[216:219], v9, s[48:51], s33 offen
  v_add_u32 v22, s56, v18
  v_add_u32 v23, s56, v19
  v_add_u32 v24, s56, v20
  v_add_u32 v25, s56, v21
  v_and_b32 v48, 31, v1
  s_lshl_b32 s61, s52, 12
  s_add_u32 s61, s61, 0x310000
  v_lshl_add_u32 v48, v48, 7, s61
  s_mov_b32 s69, 0
  s_mov_b32 s34, 0x0c0c0400
  s_mov_b32 s35, 0x04000c0c
  s_mov_b32 s36, s12
  s_mov_b32 s37, s13
  s_mov_b32 s38, 0x400000
  s_mov_b32 s39, 0x20000
  s_lshr_b32 s62, s53, 3
  s_lshl_b32 s63, s52, 2
  s_add_u32 s62, s62, s63
  s_lshl_b32 s4, s62, 17
  s_add_u32 s4, s4, s56
  s_and_b32 s61, s53, 7
  s_lshl_b32 s61, s61, 7
  s_add_u32 s4, s4, s61
  s_lshl_b32 s5, s3, 11
  s_add_u32 s5, s5, 147456
  s_cmp_eq_u32 s3, 0
  s_cbranch_scc0 L_noxf
  s_getreg_b32 s64, hwreg(HW_REG_XCC_ID)
  s_and_b32 s64, s64, 15
  s_lshl_b32 s64, s64, 28
  v_mov_b32 v208, v50
  v_or_b32 v209, s64, v51
  s_lshl_b32 s64, s53, 7
  s_mov_b64 exec, 1
  buffer_store_dwordx2 v[208:209], v48, s[48:51], s64 offen sc1
  s_mov_b64 exec, -1
L_noxf:
  s_lshl_b32 s61, s3, 18
  s_and_b32 s63, s53, 7
  s_lshl_b32 s63, s63, 13
  s_add_u32 s61, s61, s63
  s_lshl_b32 s63, s62, 8
  s_add_u32 s61, s61, s63
  s_add_u32 s61, s61, 0x400000
  v_lshlrev_b32 v36, 16, v4
  v_lshl_add_u32 v36, v5, 6, v36
  v_lshl_add_u32 v36, v3, 4, v36
  v_add_u32 v36, s61, v36
  s_waitcnt vmcnt(3)
  s_add_u32 m0, s56, 4096
  s_nop 0
  buffer_load_dwordx4 v14, s[24:27], s58 offen offset:2048 nt lds
  ds_read_b128 v[56:59], v22 offset:0
  ds_read_b128 v[60:63], v23 offset:0
  ds_read_b128 v[64:67], v24 offset:0
  ds_read_b128 v[68:71], v25 offset:0
  s_lshl_b32 s11, s52, 18
  s_lshl_b32 s61, s54, 15
  s_add_u32 s11, s11, s61
  s_lshl_b32 s61, s3, 10
  s_add_u32 s11, s11, s61
  v_lshrrev_b32 v9, 5, v1
  v_bfe_u32 v47, v1, 1, 4
  v_xor_b32 v47, v47, v9
  s_lshl_b32 s61, s3, 1
  v_xor_b32 v47, s61, v47
  v_lshlrev_b32 v47, 4, v47
  v_lshl_add_u32 v47, v9, 8, v47
  v_and_b32 v9, 1, v1
  v_lshl_add_u32 v47, v9, 3, v47
  s_lshl_b32 s61, s3, 9
  s_add_u32 s61, s61, 131072
  v_add_u32 v47, s61, v47
  s_waitcnt vmcnt(3)
  s_add_u32 m0, s56, 4096
  s_nop 0
  buffer_load_dwordx4 v15, s[24:27], s58 offen offset:3072 nt lds
  s_mov_b32 s28, s8
  s_mov_b32 s29, s9
  s_mov_b32 s30, 0x2000000
  s_mov_b32 s31, 0x20000
  s_mov_b32 s40, s14
  s_mov_b32 s41, s15
  s_mov_b32 s42, 0x8000
  s_mov_b32 s43, 0x20000
  v_lshlrev_b32 v9, 1, v3
  v_xor_b32 v9, v9, v2
  v_lshl_add_u32 v16, v9, 4, v8
  v_xor_b32 v9, 8, v9
  v_lshl_add_u32 v17, v9, 4, v8
  s_waitcnt vmcnt(3)
  s_add_u32 m0, s56, 8192
  s_nop 0
  buffer_load_dwordx4 v12, s[24:27], s59 offen offset:0 nt lds
  s_bitcmp0_b32 s69, 0
  s_cselect_b64 exec, -1, 0
  s_add_u32 s64, s11, 0x0
  buffer_load_dwordx4 v[120:123], v34, s[48:51], s64 offen nt
  s_mov_b64 exec, -1
  v_mov_b32 v9, v28
  v_mov_b32 v10, v29
  v_xor_b32 v28, 0, v9
  v_lshl_add_u32 v28, v28, 4, v10
  v_xor_b32 v29, 2, v9
  v_lshl_add_u32 v29, v29, 4, v10
  v_xor_b32 v30, 4, v9
  v_lshl_add_u32 v30, v30, 4, v10
  v_xor_b32 v31, 6, v9
  v_lshl_add_u32 v31, v31, 4, v10
  s_waitcnt vmcnt(3)
  s_add_u32 m0, s56, 8192
  s_nop 0
  buffer_load_dwordx4 v13, s[24:27], s59 offen offset:1024 nt lds
  s_bitcmp0_b32 s69, 1
  s_cselect_b64 exec, -1, 0
  s_add_u32 s64, s11, 0x2000
  buffer_load_dwordx4 v[124:127], v34, s[48:51], s64 offen nt
  s_mov_b64 exec, -1
  s_lshl_b32 s61, s2, 12
  s_lshl_b32 s63, s3, 9
  s_add_u32 s61, s61, s63
  s_add_u32 s61, s61, 0x200000
  v_lshlrev_b32 v35, 5, v2
  v_lshl_add_u32 v35, v3, 3, v35
  v_add_u32 v35, s61, v35
  s_lshl_b32 s61, s2, 8
  s_add_u32 s61, s61, 0x300000
  v_lshlrev_b32 v37, 4, v2
  v_add_u32 v37, s61, v37
  s_waitcnt vmcnt(4)
  s_add_u32 m0, s56, 8192
  s_nop 0
  buffer_load_dwordx4 v14, s[24:27], s59 offen offset:2048 nt lds
  ds_read_b128 v[72:75], v22 offset:4096
  ds_read_b128 v[76:79], v23 offset:4096
  ds_read_b128 v[80:83], v24 offset:4096
  ds_read_b128 v[84:87], v25 offset:4096
  s_bitcmp0_b32 s69, 2
  s_cselect_b64 exec, -1, 0
  s_add_u32 s64, s11, 0x4000
  buffer_load_dwordx4 v[128:131], v34, s[48:51], s64 offen nt
  s_mov_b64 exec, -1
  v_lshl_add_u32 v11, v3, 2, v5
  v_and_b32 v26, 7, v11
  v_lshlrev_b32 v26, 1, v26
  v_lshrrev_b32 v27, 1, v4
  s_lshl_b32 s61, s3, 1
  v_add_u32 v27, s61, v27
  v_xor_b32 v26, v26, v27
  v_lshlrev_b32 v26, 4, v26
  v_lshl_add_u32 v26, v11, 8, v26
  v_and_b32 v27, 1, v2
  v_lshl_add_u32 v26, v27, 3, v26
  v_add_u32 v27, 0x10000, v26
  s_waitcnt vmcnt(5)
  s_add_u32 m0, s56, 8192
  s_nop 0
  buffer_load_dwordx4 v15, s[24:27], s59 offen offset:3072 nt lds
  s_bitcmp0_b32 s69, 3
  s_cselect_b64 exec, -1, 0
  s_add_u32 s64, s11, 0x6000
  buffer_load_dwordx4 v[132:135], v34, s[48:51], s64 offen nt
  s_mov_b64 exec, -1
  s_lshl_b32 s61, s3, 2
  s_add_u32 s61, s61, 147456
  v_lshlrev_b32 v41, 5, v2
  v_add_u32 v40, s61, v41
  v_add_u32 v41, 147456, v41
  s_lshr_b32 s61, s3, 1
  s_lshl_b32 s61, s61, 10
  s_and_b32 s62, s3, 1
  s_lshl_b32 s62, s62, 3
  s_add_u32 s61, s61, s62
  s_add_u32 s61, s61, 131072
  v_add_u32 v42, s61, v34
  s_waitcnt vmcnt(5)
  s_add_u32 m0, s56, 12288
  s_nop 0
  buffer_load_dwordx4 v12, s[24:27], s60 offen offset:0 nt lds
  v_perm_b32 v224, v121, v120, s34
  v_perm_b32 v225, v123, v122, s35
  v_or_b32 v224, v224, v225
  v_cmp_ne_u32 vcc, v224, v46
  s_cmp_eq_u64 vcc, 0
  s_cselect_b32 s64, 1, 0
  s_or_b32 s69, s69, s64
  s_bitcmp0_b32 s69, 0
  s_cselect_b64 exec, -1, 0
  s_add_u32 s64, s11, 0x0
  buffer_load_dwordx4 v[120:123], v34, s[48:51], s64 offen nt
  s_mov_b64 exec, -1
  v_lshlrev_b32 v38, 15, v5
  v_lshl_add_u32 v38, v4, 5, v38
  v_lshrrev_b32 v39, 1, v3
  v_lshl_add_u32 v38, v39, 9, v38
  v_and_b32 v39, 1, v3
  v_lshl_add_u32 v38, v39, 4, v38
  v_lshlrev_b32 v39, 11, v5
  v_lshl_add_u32 v39, v4, 4, v39
  s_waitcnt vmcnt(5)
  s_add_u32 m0, s56, 12288
  s_nop 0
  buffer_load_dwordx4 v13, s[24:27], s60 offen offset:1024 nt lds
  v_perm_b32 v224, v125, v124, s34
  v_perm_b32 v225, v127, v126, s35
  v_or_b32 v224, v224, v225
  v_cmp_ne_u32 vcc, v224, v46
  s_cmp_eq_u64 vcc, 0
  s_cselect_b32 s64, 2, 0
  s_or_b32 s69, s69, s64
  s_bitcmp0_b32 s69, 1
  s_cselect_b64 exec, -1, 0
  s_add_u32 s64, s11, 0x2000
  buffer_load_dwordx4 v[124:127], v34, s[48:51], s64 offen nt
  s_mov_b64 exec, -1
  s_lshr_b32 s61, s53, 3
  s_lshl_b32 s66, s52, 12
  s_lshl_b32 s62, s3, 17
  s_add_u32 s66, s66, s62
  s_lshl_b32 s62, s61, 7
  s_add_u32 s66, s66, s62
  s_add_u32 s66, s66, 0x200000
  s_lshl_b32 s67, s52, 8
  s_lshl_b32 s62, s3, 13
  s_add_u32 s67, s67, s62
  s_lshl_b32 s62, s61, 6
  s_add_u32 s67, s67, s62
  s_add_u32 s67, s67, 0x300000
  s_mov_b32 s68, 0x3e0293ee
  s_waitcnt vmcnt(5)
  s_add_u32 m0, s56, 12288
  s_nop 0
  buffer_load_dwordx4 v14, s[24:27], s60 offen offset:2048 nt lds
  ds_read_b128 v[88:91], v22 offset:8192
  ds_read_b128 v[92:95], v23 offset:8192
  ds_read_b128 v[96:99], v24 offset:8192
  ds_read_b128 v[100:103], v25 offset:8192
  v_perm_b32 v224, v129, v128, s34
  v_perm_b32 v225, v131, v130, s35
  v_or_b32 v224, v224, v225
  v_cmp_ne_u32 vcc, v224, v46
  s_cmp_eq_u64 vcc, 0
  s_cselect_b32 s64, 4, 0
  s_or_b32 s69, s69, s64
  s_bitcmp0_b32 s69, 2
  s_cselect_b64 exec, -1, 0
  s_add_u32 s64, s11, 0x4000
  buffer_load_dwordx4 v[128:131], v34, s[48:51], s64 offen nt
  s_mov_b64 exec, -1
  s_waitcnt vmcnt(5)
  s_add_u32 m0, s56, 12288
  s_nop 0
  buffer_load_dwordx4 v15, s[24:27], s60 offen offset:3072 nt lds
  v_perm_b32 v224, v133, v132, s34
  v_perm_b32 v225, v135, v134, s35
  v_or_b32 v224, v224, v225
  v_cmp_ne_u32 vcc, v224, v46
  s_cmp_eq_u64 vcc, 0
  s_cselect_b32 s64, 8, 0
  s_or_b32 s69, s69, s64
  s_bitcmp0_b32 s69, 3
  s_cselect_b64 exec, -1, 0
  s_add_u32 s64, s11, 0x6000
  buffer_load_dwordx4 v[132:135], v34, s[48:51], s64 offen nt
  s_mov_b64 exec, -1
  s_waitcnt vmcnt(5)
  s_waitcnt lgkmcnt(0)
  s_add_u32 m0, s56, 0
  s_nop 0
  buffer_load_dwordx4 v16, s[28:31], s57 offen offset:0 nt lds
  v_perm_b32 v224, v121, v120, s34
  v_perm_b32 v225, v123, v122, s35
  v_or_b32 v224, v224, v225
  v_cmp_ne_u32 vcc, v224, v46
  s_cmp_eq_u64 vcc, 0
  s_cselect_b32 s64, 1, 0
  s_or_b32 s69, s69, s64
  s_bitcmp0_b32 s69, 0
  s_cselect_b64 exec, -1, 0
  s_add_u32 s64, s11, 0x0
  buffer_load_dwordx4 v[120:123], v34, s[48:51], s64 offen nt
  s_mov_b64 exec, -1
  s_waitcnt vmcnt(5)
  s_add_u32 m0, s56, 0
  s_nop 0
  buffer_load_dwordx4 v17, s[28:31], s57 offen offset:1024 nt lds
  v_perm_b32 v224, v125, v124, s34
  v_perm_b32 v225, v127, v126, s35
  v_or_b32 v224, v224, v225
  v_cmp_ne_u32 vcc, v224, v46
  s_cmp_eq_u64 vcc, 0
  s_cselect_b32 s64, 2, 0
  s_or_b32 s69, s69, s64
  s_bitcmp0_b32 s69, 1
  s_cselect_b64 exec, -1, 0
  s_add_u32 s64, s11, 0x2000
  buffer_load_dwordx4 v[124:127], v34, s[48:51], s64 offen nt
  s_mov_b64 exec, -1
  s_waitcnt vmcnt(5)
  s_add_u32 m0, s56, 0
  s_nop 0
  buffer_load_dwordx4 v16, s[28:31], s57 offen offset:2048 nt lds
  ds_read_b128 v[104:107], v22 offset:12288
  ds_read_b128 v[108:111], v23 offset:12288
  ds_read_b128 v[112:115], v24 offset:12288
  ds_read_b128 v[116:119], v25 offset:12288
  v_perm_b32 v224, v129, v128, s34
  v_perm_b32 v225, v131, v130, s35
  v_or_b32 v224, v224, v225
  v_cmp_ne_u32 vcc, v224, v46
  s_cmp_eq_u64 vcc, 0
  s_cselect_b32 s64, 4, 0
  s_or_b32 s69, s69, s64
  s_waitcnt vmcnt(4)
  s_add_u32 m0, s56, 0
  s_nop 0
  buffer_load_dwordx4 v17, s[28:31], s57 offen offset:3072 nt lds
  v_perm_b32 v224, v133, v132, s34
  v_perm_b32 v225, v135, v134, s35
  v_or_b32 v224, v224, v225
  v_cmp_ne_u32 vcc, v224, v46
  s_cmp_eq_u64 vcc, 0
  s_cselect_b32 s64, 8, 0
  s_or_b32 s69, s69, s64
  s_waitcnt vmcnt(3)
  s_waitcnt lgkmcnt(0)
  s_add_u32 m0, s56, 4096
  s_nop 0
  buffer_load_dwordx4 v16, s[28:31], s58 offen offset:0 nt lds
  v_perm_b32 v224, v121, v120, s34
  v_perm_b32 v225, v123, v122, s35
  v_or_b32 v224, v224, v225
  v_cmp_ne_u32 vcc, v224, v46
  s_cmp_eq_u64 vcc, 0
  s_cselect_b32 s64, 1, 0
  s_or_b32 s69, s69, s64
  s_waitcnt lgkmcnt(0)
  s_add_u32 m0, s56, 4096
  s_nop 0
  buffer_load_dwordx4 v17, s[28:31], s58 offen offset:1024 nt lds
  s_add_u32 m0, s56, 4096
  s_nop 0
  buffer_load_dwordx4 v16, s[28:31], s58 offen offset:2048 nt lds
  s_waitcnt vmcnt(5)
  v_perm_b32 v224, v125, v124, s34
  v_perm_b32 v225, v127, v126, s35
  v_or_b32 v224, v224, v225
  v_cmp_ne_u32 vcc, v224, v46
  s_cmp_eq_u64 vcc, 0
  s_cselect_b32 s64, 2, 0
  s_or_b32 s69, s69, s64
  s_cmp_eq_u32 s69, 15
  s_cbranch_scc1 L_qdone
  s_mov_b32 s65, 0
L_pollchk:
  s_add_u32 s64, s11, 0x0
  buffer_load_dwordx4 v[120:123], v34, s[48:51], s64 offen nt
  s_add_u32 s64, s11, 0x2000
  buffer_load_dwordx4 v[124:127], v34, s[48:51], s64 offen nt
  s_add_u32 s64, s11, 0x4000
  buffer_load_dwordx4 v[128:131], v34, s[48:51], s64 offen nt
  s_add_u32 s64, s11, 0x6000
  buffer_load_dwordx4 v[132:135], v34, s[48:51], s64 offen nt
  s_waitcnt vmcnt(0)
  s_mov_b32 s69, 0
  v_perm_b32 v224, v121, v120, s34
  v_perm_b32 v225, v123, v122, s35
  v_or_b32 v224, v224, v225
  v_cmp_ne_u32 vcc, v224, v46
  s_cmp_eq_u64 vcc, 0
  s_cselect_b32 s64, 1, 0
  s_or_b32 s69, s69, s64
  v_perm_b32 v224, v125, v124, s34
  v_perm_b32 v225, v127, v126, s35
  v_or_b32 v224, v224, v225
  v_cmp_ne_u32 vcc, v224, v46
  s_cmp_eq_u64 vcc, 0
  s_cselect_b32 s64, 2, 0
  s_or_b32 s69, s69, s64
  v_perm_b32 v224, v129, v128, s34
  v_perm_b32 v225, v131, v130, s35
  v_or_b32 v224, v224, v225
  v_cmp_ne_u32 vcc, v224, v46
  s_cmp_eq_u64 vcc, 0
  s_cselect_b32 s64, 4, 0
  s_or_b32 s69, s69, s64
  v_perm_b32 v224, v133, v132, s34
  v_perm_b32 v225, v135, v134, s35
  v_or_b32 v224, v224, v225
  v_cmp_ne_u32 vcc, v224, v46
  s_cmp_eq_u64 vcc, 0
  s_cselect_b32 s64, 8, 0
  s_or_b32 s69, s69, s64
  s_cmp_eq_u32 s69, 15
  s_cbranch_scc1 L_pollok
  s_and_b32 s64, s65, 3
  s_cmp_eq_u32 s64, 3
  s_cbranch_scc0 L_pollnx
  buffer_load_dwordx2 v[52:53], v48, s[48:51], 0 offen sc1
  s_getreg_b32 s64, hwreg(HW_REG_XCC_ID)
  s_and_b32 s64, s64, 15
  s_lshl_b32 s64, s64, 28
  s_waitcnt vmcnt(0)
  v_xor_b32 v52, v52, v50
  v_xor_b32 v53, v53, v51
  v_and_b32 v208, 0xfffffff, v53
  v_or_b32 v208, v208, v52
  v_cmp_eq_u32 vcc, 0, v208
  v_cmp_ne_u32 s[70:71], s64, v53
  s_and_b64 vcc, vcc, s[70:71]
  s_cbranch_scc0 L_pollnx
  v_mov_b32 v208, 1
  v_mov_b32 v209, v50
  v_mov_b32 v210, v51
  v_mov_b32 v211, 0
  v_mov_b32 v52, 135168
  ds_write_b128 v52, v[208:211]
  s_branch L_qskip
L_pollnx:
  s_add_u32 s65, s65, 1
  s_cmp_gt_u32 s65, 0x8000
  s_cbranch_scc1 L_pollok
  s_branch L_pollchk
L_pollok:
L_qdone:
  v_and_b32 v120, 0xffffff00, v120
  v_and_b32 v121, 0xffffff00, v121
  v_and_b32 v122, 0xffffff00, v122
  v_and_b32 v123, 0xffffff00, v123
  v_and_b32 v124, 0xffffff00, v124
  v_and_b32 v125, 0xffffff00, v125
  v_and_b32 v126, 0xffffff00, v126
  v_and_b32 v127, 0xffffff00, v127
  v_and_b32 v128, 0xffffff00, v128
  v_and_b32 v129, 0xffffff00, v129
  v_and_b32 v130, 0xffffff00, v130
  v_and_b32 v131, 0xffffff00, v131
  v_and_b32 v132, 0xffffff00, v132
  v_and_b32 v133, 0xffffff00, v133
  v_and_b32 v134, 0xffffff00, v134
  v_and_b32 v135, 0xffffff00, v135
  v_add_f32 v120, v120, v124
  v_add_f32 v128, v128, v132
  v_add_f32 v121, v121, v125
  v_add_f32 v129, v129, v133
  v_add_f32 v122, v122, v126
  v_add_f32 v130, v130, v134
  v_add_f32 v123, v123, v127
  v_add_f32 v131, v131, v135
  v_add_f32 v120, v120, v128
  v_add_f32 v121, v121, v129
  v_add_f32 v122, v122, v130
  v_add_f32 v123, v123, v131
  v_cvt_pk_bf16_f32 v120, v120, v121
  v_cvt_pk_bf16_f32 v121, v122, v123
  ds_write_b64 v47, v[120:121]
L_qskip:
  s_waitcnt lgkmcnt(0)
  s_barrier
  v_mov_b32 v8, 135168
  ds_read_b128 v[224:227], v8
  v_add_u32 v4, 131072, v18
  v_add_u32 v5, 131072, v19
  v_add_u32 v6, 131072, v20
  v_add_u32 v7, 131072, v21
  ds_read_b128 v[184:187], v4
  ds_read_b128 v[188:191], v5
  ds_read_b128 v[192:195], v6
  ds_read_b128 v[196:199], v7
  s_waitcnt lgkmcnt(4)
  v_xor_b32 v224, 1, v224
  v_xor_b32 v225, v225, v50
  v_xor_b32 v226, v226, v51
  v_or3_b32 v224, v224, v225, v226
  v_cmp_eq_u32 vcc, 0, v224
  s_cmp_lg_u64 vcc, 0
  s_cselect_b32 s6, 1, 0
  s_cbranch_scc1 L_slow
L_fast:
  s_add_u32 m0, s56, 4096
  s_nop 0
  buffer_load_dwordx4 v17, s[28:31], s58 offen offset:3072 nt lds
  s_waitcnt lgkmcnt(3)
  v_mfma_f32_16x16x32_bf16 v[200:203], v[56:59], v[184:187], 0
  v_mfma_f32_16x16x32_bf16 v[204:207], v[72:75], v[184:187], 0
  v_mfma_f32_16x16x32_bf16 v[208:211], v[88:91], v[184:187], 0
  v_mfma_f32_16x16x32_bf16 v[212:215], v[104:107], v[184:187], 0
  s_waitcnt lgkmcnt(2)
  v_mfma_f32_16x16x32_bf16 v[200:203], v[60:63], v[188:191], v[200:203]
  v_mfma_f32_16x16x32_bf16 v[204:207], v[76:79], v[188:191], v[204:207]
  v_mfma_f32_16x16x32_bf16 v[208:211], v[92:95], v[188:191], v[208:211]
  v_mfma_f32_16x16x32_bf16 v[212:215], v[108:111], v[188:191], v[212:215]
  s_waitcnt lgkmcnt(1)
  v_mfma_f32_16x16x32_bf16 v[200:203], v[64:67], v[192:195], v[200:203]
  v_mfma_f32_16x16x32_bf16 v[204:207], v[80:83], v[192:195], v[204:207]
  v_mfma_f32_16x16x32_bf16 v[208:211], v[96:99], v[192:195], v[208:211]
  v_mfma_f32_16x16x32_bf16 v[212:215], v[112:115], v[192:195], v[212:215]
  s_waitcnt lgkmcnt(0)
  v_mfma_f32_16x16x32_bf16 v[200:203], v[68:71], v[196:199], v[200:203]
  v_mfma_f32_16x16x32_bf16 v[204:207], v[84:87], v[196:199], v[204:207]
  v_mfma_f32_16x16x32_bf16 v[208:211], v[100:103], v[196:199], v[208:211]
  v_mfma_f32_16x16x32_bf16 v[212:215], v[116:119], v[196:199], v[212:215]
  s_add_u32 m0, s56, 8192
  s_nop 0
  buffer_load_dwordx4 v16, s[28:31], s59 offen offset:0 nt lds
  s_nop 4
  v_max3_f32 v43, v200, v201, v202
  v_max3_f32 v43, v43, v203, v204
  v_max3_f32 v43, v43, v205, v206
  v_max3_f32 v43, v43, v207, v208
  v_max3_f32 v43, v43, v209, v210
  v_max3_f32 v43, v43, v211, v212
  v_max3_f32 v43, v43, v213, v214
  v_max_f32 v43, v43, v215
  v_mov_b32 v5, v43
  s_nop 1
  v_permlane32_swap_b32 v43, v5
  v_max_f32 v43, v43, v5
  v_mov_b32 v5, v43
  s_nop 1
  v_permlane16_swap_b32 v43, v5
  v_max_f32 v43, v43, v5
  ds_write_b32 v40, v43
  s_waitcnt lgkmcnt(0)
  s_barrier
  ds_read_b128 v[216:219], v41
  ds_read_b128 v[220:223], v41 offset:16
  s_add_u32 m0, s56, 8192
  s_nop 0
  buffer_load_dwordx4 v17, s[28:31], s59 offen offset:1024 nt lds
  s_waitcnt lgkmcnt(0)
  v_max3_f32 v43, v216, v217, v218
  v_max3_f32 v43, v43, v219, v220
  v_max3_f32 v43, v43, v221, v222
  v_max_f32 v43, v43, v223
  v_mul_f32 v43, s68, v43
  v_fma_f32 v200, v200, s68, -v43
  v_fma_f32 v201, v201, s68, -v43
  v_fma_f32 v202, v202, s68, -v43
  v_fma_f32 v203, v203, s68, -v43
  v_fma_f32 v204, v204, s68, -v43
  v_fma_f32 v205, v205, s68, -v43
  v_fma_f32 v206, v206, s68, -v43
  v_fma_f32 v207, v207, s68, -v43
  v_fma_f32 v208, v208, s68, -v43
  v_fma_f32 v209, v209, s68, -v43
  v_fma_f32 v210, v210, s68, -v43
  v_fma_f32 v211, v211, s68, -v43
  v_fma_f32 v212, v212, s68, -v43
  v_fma_f32 v213, v213, s68, -v43
  v_fma_f32 v214, v214, s68, -v43
  v_fma_f32 v215, v215, s68, -v43
  v_exp_f32 v200, v200
  v_exp_f32 v201, v201
  v_exp_f32 v202, v202
  v_exp_f32 v203, v203
  v_exp_f32 v204, v204
  v_exp_f32 v205, v205
  v_exp_f32 v206, v206
  v_exp_f32 v207, v207
  v_exp_f32 v208, v208
  v_exp_f32 v209, v209
  v_exp_f32 v210, v210
  v_exp_f32 v211, v211
  v_exp_f32 v212, v212
  v_exp_f32 v213, v213
  v_exp_f32 v214, v214
  v_exp_f32 v215, v215
  s_nop 0
  v_cvt_pk_bf16_f32 v216, v200, v201
  v_cvt_pk_bf16_f32 v217, v202, v203
  ds_write_b64 v42, v[216:217] offset:0
  v_cvt_pk_bf16_f32 v218, v204, v205
  v_cvt_pk_bf16_f32 v219, v206, v207
  ds_write_b64 v42, v[218:219] offset:4096
  v_cvt_pk_bf16_f32 v220, v208, v209
  v_cvt_pk_bf16_f32 v221, v210, v211
  ds_write_b64 v42, v[220:221] offset:8192
  v_cvt_pk_bf16_f32 v222, v212, v213
  v_cvt_pk_bf16_f32 v223, v214, v215
  ds_write_b64 v42, v[222:223] offset:12288
  s_add_u32 m0, s56, 8192
  s_nop 0
  buffer_load_dwordx4 v16, s[28:31], s59 offen offset:2048 nt lds
  v_add_f32 v44, v200, v201
  v_add_f32 v44, v44, v202
  v_add_f32 v44, v44, v203
  v_add_f32 v44, v44, v204
  v_add_f32 v44, v44, v205
  v_add_f32 v44, v44, v206
  v_add_f32 v44, v44, v207
  v_add_f32 v44, v44, v208
  v_add_f32 v44, v44, v209
  v_add_f32 v44, v44, v210
  v_add_f32 v44, v44, v211
  v_add_f32 v44, v44, v212
  v_add_f32 v44, v44, v213
  v_add_f32 v44, v44, v214
  v_add_f32 v44, v44, v215
  v_mov_b32 v5, v44
  s_nop 1
  v_permlane32_swap_b32 v44, v5
  v_add_f32 v44, v44, v5
  v_mov_b32 v5, v44
  s_nop 1
  v_permlane16_swap_b32 v44, v5
  v_add_f32 v44, v44, v5
  ds_write_b32 v40, v44 offset:512
  s_waitcnt vmcnt(7)
  s_waitcnt lgkmcnt(0)
  s_barrier
  s_cmp_eq_u32 s3, 7
  s_cbranch_scc0 L_nostats
  ds_read_b128 v[200:203], v41 offset:512
  ds_read_b128 v[204:207], v41 offset:528
  v_mov_b32 v184, -1
  v_mov_b32 v185, -1
  v_mov_b32 v186, -1
  v_mov_b32 v187, -1
  s_lshl_b32 s61, s2, 12
  s_add_u32 s61, s61, 0x200000
  s_cmp_eq_u32 s6, 0
  s_cbranch_scc0 L_msclra
  buffer_store_dwordx4 v[184:187], v34, s[48:51], s61 offen offset:0
  buffer_store_dwordx4 v[184:187], v34, s[48:51], s61 offen offset:1024
  buffer_store_dwordx4 v[184:187], v34, s[48:51], s61 offen offset:2048
  buffer_store_dwordx4 v[184:187], v34, s[48:51], s61 offen offset:3072
  s_branch L_msclrb
L_msclra:
  buffer_store_dwordx4 v[184:187], v34, s[48:51], s61 offen offset:0 sc1
  buffer_store_dwordx4 v[184:187], v34, s[48:51], s61 offen offset:1024 sc1
  buffer_store_dwordx4 v[184:187], v34, s[48:51], s61 offen offset:2048 sc1
  buffer_store_dwordx4 v[184:187], v34, s[48:51], s61 offen offset:3072 sc1
L_msclrb:
  s_waitcnt lgkmcnt(0)
  v_add_f32 v200, v200, v201
  v_add_f32 v200, v200, v202
  v_add_f32 v200, v200, v203
  v_add_f32 v200, v200, v204
  v_add_f32 v200, v200, v205
  v_add_f32 v200, v200, v206
  v_add_f32 v200, v200, v207
  v_mov_b32 v202, v200
  v_mov_b32 v200, v43
  v_mov_b32 v201, s7
  v_mov_b32 v203, s10
L_nostats:
  s_add_u32 m0, s56, 8192
  s_nop 0
  buffer_load_dwordx4 v17, s[28:31], s59 offen offset:3072 nt lds
  v_add_u32 v4, 131072, v34
  ds_read_b128 v[56:59], v4 offset:0
  ds_read_b128 v[60:63], v4 offset:1024
  ds_read_b128 v[64:67], v4 offset:2048
  ds_read_b128 v[68:71], v4 offset:3072
  ds_read_b128 v[72:75], v4 offset:4096
  ds_read_b128 v[76:79], v4 offset:5120
  ds_read_b128 v[80:83], v4 offset:6144
  ds_read_b128 v[84:87], v4 offset:7168
  ds_read_b128 v[88:91], v4 offset:8192
  ds_read_b128 v[92:95], v4 offset:9216
  ds_read_b128 v[96:99], v4 offset:10240
  ds_read_b128 v[100:103], v4 offset:11264
  ds_read_b128 v[104:107], v4 offset:12288
  ds_read_b128 v[108:111], v4 offset:13312
  ds_read_b128 v[112:115], v4 offset:14336
  ds_read_b128 v[116:119], v4 offset:15360
  ds_read_b64_tr_b16 v[216:217], v26 offset:0
  ds_read_b64_tr_b16 v[218:219], v26 offset:16384
  ds_read_b64_tr_b16 v[220:221], v26 offset:32768
  ds_read_b64_tr_b16 v[222:223], v26 offset:49152
  ds_read_b64_tr_b16 v[224:225], v27 offset:0
  ds_read_b64_tr_b16 v[226:227], v27 offset:16384
  ds_read_b64_tr_b16 v[228:229], v27 offset:32768
  ds_read_b64_tr_b16 v[230:231], v27 offset:49152
  s_waitcnt lgkmcnt(6)
  v_mfma_f32_16x16x32_bf16 v[248:251], v[216:219], v[56:59], 0
  s_waitcnt lgkmcnt(4)
  v_mfma_f32_16x16x32_bf16 v[252:255], v[220:223], v[60:63], 0
  s_waitcnt lgkmcnt(2)
  v_mfma_f32_16x16x32_bf16 v[248:251], v[224:227], v[64:67], v[248:251]
  s_waitcnt lgkmcnt(0)
  v_mfma_f32_16x16x32_bf16 v[252:255], v[228:231], v[68:71], v[252:255]
  s_waitcnt vmcnt(7)
  s_add_u32 m0, s56, 12288
  s_nop 0
  buffer_load_dwordx4 v16, s[28:31], s60 offen offset:0 nt lds
  s_waitcnt vmcnt(7)
  s_add_u32 m0, s56, 12288
  s_nop 0
  buffer_load_dwordx4 v17, s[28:31], s60 offen offset:1024 nt lds
  s_waitcnt vmcnt(7)
  s_add_u32 m0, s56, 12288
  s_nop 0
  buffer_load_dwordx4 v16, s[28:31], s60 offen offset:2048 nt lds
  s_waitcnt vmcnt(7)
  s_add_u32 m0, s56, 12288
  s_nop 0
  buffer_load_dwordx4 v17, s[28:31], s60 offen offset:3072 nt lds
  s_waitcnt lgkmcnt(0)
  s_cmp_eq_u32 s3, 7
  s_cbranch_scc0 L_f2st
  s_waitcnt vmcnt(5)
  s_mov_b64 exec, 0xffff
  s_cmp_eq_u32 s6, 0
  s_cbranch_scc0 L_mssta
  buffer_store_dwordx4 v[200:203], v37, s[48:51], 0 offen
  s_branch L_msstb
L_mssta:
  buffer_store_dwordx4 v[200:203], v37, s[48:51], 0 offen sc1
L_msstb:
  s_mov_b64 exec, -1
L_f2st:
  s_barrier
  ds_read_b64_tr_b16 v[232:233], v26 offset:4096
  ds_read_b64_tr_b16 v[234:235], v26 offset:20480
  ds_read_b64_tr_b16 v[236:237], v26 offset:36864
  ds_read_b64_tr_b16 v[238:239], v26 offset:53248
  ds_read_b64_tr_b16 v[240:241], v27 offset:4096
  ds_read_b64_tr_b16 v[242:243], v27 offset:20480
  ds_read_b64_tr_b16 v[244:245], v27 offset:36864
  ds_read_b64_tr_b16 v[246:247], v27 offset:53248
  s_waitcnt lgkmcnt(6)
  v_mfma_f32_16x16x32_bf16 v[248:251], v[232:235], v[72:75], v[248:251]
  s_waitcnt lgkmcnt(4)
  v_mfma_f32_16x16x32_bf16 v[252:255], v[236:239], v[76:79], v[252:255]
  s_waitcnt lgkmcnt(2)
  v_mfma_f32_16x16x32_bf16 v[248:251], v[240:243], v[80:83], v[248:251]
  s_waitcnt lgkmcnt(0)
  v_mfma_f32_16x16x32_bf16 v[252:255], v[244:247], v[84:87], v[252:255]
  s_waitcnt vmcnt(7)
  s_waitcnt vmcnt(6)
  s_waitcnt vmcnt(5)
  s_waitcnt vmcnt(4)
  s_waitcnt lgkmcnt(0)
  s_barrier
  ds_read_b64_tr_b16 v[216:217], v26 offset:8192
  ds_read_b64_tr_b16 v[218:219], v26 offset:24576
  ds_read_b64_tr_b16 v[220:221], v26 offset:40960
  ds_read_b64_tr_b16 v[222:223], v26 offset:57344
  ds_read_b64_tr_b16 v[224:225], v27 offset:8192
  ds_read_b64_tr_b16 v[226:227], v27 offset:24576
  ds_read_b64_tr_b16 v[228:229], v27 offset:40960
  ds_read_b64_tr_b16 v[230:231], v27 offset:57344
  s_waitcnt lgkmcnt(6)
  v_mfma_f32_16x16x32_bf16 v[248:251], v[216:219], v[88:91], v[248:251]
  s_waitcnt lgkmcnt(4)
  v_mfma_f32_16x16x32_bf16 v[252:255], v[220:223], v[92:95], v[252:255]
  s_waitcnt lgkmcnt(2)
  v_mfma_f32_16x16x32_bf16 v[248:251], v[224:227], v[96:99], v[248:251]
  s_waitcnt lgkmcnt(0)
  v_mfma_f32_16x16x32_bf16 v[252:255], v[228:231], v[100:103], v[252:255]
  buffer_load_dwordx4 v[208:211], v39, s[48:51], s67 offen sc1
  s_add_u32 m0, s5, 0
  s_nop 0
  buffer_load_dwordx4 v32, s[36:39], s4 offen nt lds
  s_add_u32 m0, s5, 1024
  s_nop 0
  buffer_load_dwordx4 v33, s[36:39], s4 offen nt lds
  v_mov_b32 v184, -1
  v_mov_b32 v185, -1
  v_mov_b32 v186, -1
  v_mov_b32 v187, -1
  v_mov_b32 v188, -1
  v_mov_b32 v189, -1
  v_mov_b32 v190, -1
  v_mov_b32 v191, -1
  v_mov_b32 v192, -1
  v_mov_b32 v193, -1
  v_mov_b32 v194, -1
  v_mov_b32 v195, -1
  v_mov_b32 v196, -1
  v_mov_b32 v197, -1
  v_mov_b32 v198, -1
  v_mov_b32 v199, -1
  s_waitcnt vmcnt(6)
  s_waitcnt vmcnt(5)
  s_waitcnt vmcnt(4)
  s_waitcnt vmcnt(3)
  s_waitcnt lgkmcnt(0)
  s_barrier
  ds_read_b64_tr_b16 v[232:233], v26 offset:12288
  ds_read_b64_tr_b16 v[234:235], v26 offset:28672
  ds_read_b64_tr_b16 v[236:237], v26 offset:45056
  ds_read_b64_tr_b16 v[238:239], v26 offset:61440
  ds_read_b64_tr_b16 v[240:241], v27 offset:12288
  ds_read_b64_tr_b16 v[242:243], v27 offset:28672
  ds_read_b64_tr_b16 v[244:245], v27 offset:45056
  ds_read_b64_tr_b16 v[246:247], v27 offset:61440
  s_waitcnt lgkmcnt(6)
  v_mfma_f32_16x16x32_bf16 v[248:251], v[232:235], v[104:107], v[248:251]
  s_waitcnt lgkmcnt(4)
  v_mfma_f32_16x16x32_bf16 v[252:255], v[236:239], v[108:111], v[252:255]
  s_waitcnt lgkmcnt(2)
  v_mfma_f32_16x16x32_bf16 v[248:251], v[240:243], v[112:115], v[248:251]
  s_waitcnt lgkmcnt(0)
  v_mfma_f32_16x16x32_bf16 v[252:255], v[244:247], v[116:119], v[252:255]
  v_mov_b32 v4, s7
  v_lshrrev_b32 v5, 8, v4
  v_lshrrev_b32 v6, 16, v4
  v_lshrrev_b32 v7, 24, v4
  v_mov_b32 v8, 0xff
  s_nop 2
  v_add_f32 v248, v248, v252
  v_add_f32 v249, v249, v253
  v_add_f32 v250, v250, v254
  v_add_f32 v251, v251, v255
  v_cvt_pk_bf16_f32 v248, v248, v249
  v_cvt_pk_bf16_f32 v249, v250, v251
  v_min_u32 v248, -2, v248
  v_min_u32 v249, -2, v249
  s_cmp_eq_u32 s6, 0
  s_cbranch_scc0 L_msoa
  buffer_store_dwordx2 v[248:249], v35, s[48:51], 0 offen
  s_branch L_msob
L_msoa:
  buffer_store_dwordx2 v[248:249], v35, s[48:51], 0 offen sc1
L_msob:
  s_mov_b32 s65, 0
  s_waitcnt vmcnt(3)
  v_xor_b32 v9, s7, v209
  v_xor_b32 v10, s10, v211
  v_or_b32 v9, v9, v10
  v_cmp_eq_u32 vcc, 0, v9
  s_mov_b64 exec, vcc
  s_cmp_eq_u32 s6, 0
  s_cbranch_scc0 L_h1slowp
  buffer_load_dwordx4 v[184:187], v38, s[48:51], s66 offen offset:0 nt
  buffer_load_dwordx4 v[188:191], v38, s[48:51], s66 offen offset:1024 nt
  buffer_load_dwordx4 v[192:195], v38, s[48:51], s66 offen offset:2048 nt
  buffer_load_dwordx4 v[196:199], v38, s[48:51], s66 offen offset:3072 nt
  s_branch L_h1ldp
L_h1slowp:
  buffer_load_dwordx4 v[184:187], v38, s[48:51], s66 offen offset:0 sc1
  buffer_load_dwordx4 v[188:191], v38, s[48:51], s66 offen offset:1024 sc1
  buffer_load_dwordx4 v[192:195], v38, s[48:51], s66 offen offset:2048 sc1
  buffer_load_dwordx4 v[196:199], v38, s[48:51], s66 offen offset:3072 sc1
L_h1ldp:
  s_mov_b64 exec, -1
  s_waitcnt vmcnt(5)
  s_barrier
  ds_read_b64_tr_b16 v[120:121], v28 offset:16384
  ds_read_b64_tr_b16 v[122:123], v28 offset:16896
  ds_read_b64_tr_b16 v[124:125], v28 offset:20480
  ds_read_b64_tr_b16 v[126:127], v28 offset:20992
  ds_read_b64_tr_b16 v[128:129], v28 offset:24576
  ds_read_b64_tr_b16 v[130:131], v28 offset:25088
  ds_read_b64_tr_b16 v[132:133], v28 offset:28672
  ds_read_b64_tr_b16 v[134:135], v28 offset:29184
  ds_read_b64_tr_b16 v[136:137], v29 offset:16384
  ds_read_b64_tr_b16 v[138:139], v29 offset:16896
  ds_read_b64_tr_b16 v[140:141], v29 offset:20480
  ds_read_b64_tr_b16 v[142:143], v29 offset:20992
  ds_read_b64_tr_b16 v[144:145], v29 offset:24576
  ds_read_b64_tr_b16 v[146:147], v29 offset:25088
  ds_read_b64_tr_b16 v[148:149], v29 offset:28672
  ds_read_b64_tr_b16 v[150:151], v29 offset:29184
  ds_read_b64_tr_b16 v[152:153], v30 offset:16384
  ds_read_b64_tr_b16 v[154:155], v30 offset:16896
  ds_read_b64_tr_b16 v[156:157], v30 offset:20480
  ds_read_b64_tr_b16 v[158:159], v30 offset:20992
  ds_read_b64_tr_b16 v[160:161], v30 offset:24576
  ds_read_b64_tr_b16 v[162:163], v30 offset:25088
  ds_read_b64_tr_b16 v[164:165], v30 offset:28672
  ds_read_b64_tr_b16 v[166:167], v30 offset:29184
  ds_read_b64_tr_b16 v[168:169], v31 offset:16384
  ds_read_b64_tr_b16 v[170:171], v31 offset:16896
  ds_read_b64_tr_b16 v[172:173], v31 offset:20480
  ds_read_b64_tr_b16 v[174:175], v31 offset:20992
  ds_read_b64_tr_b16 v[176:177], v31 offset:24576
  ds_read_b64_tr_b16 v[178:179], v31 offset:25088
  ds_read_b64_tr_b16 v[180:181], v31 offset:28672
  ds_read_b64_tr_b16 v[182:183], v31 offset:29184
L_h1s:
  v_xor_b32 v9, s7, v209
  v_xor_b32 v10, s10, v211
  v_or_b32 v9, v9, v10
  v_cmp_ne_u32 vcc, 0, v9
  s_cbranch_vccz L_h1sok
  buffer_load_dwordx4 v[208:211], v39, s[48:51], s67 offen sc1
  s_waitcnt vmcnt(0)
  s_add_u32 s65, s65, 1
  s_cmp_gt_u32 s65, 0x8000
  s_cbranch_scc1 L_h1sok
  s_branch L_h1s
L_h1sok:
  s_mov_b32 s65, 0
  v_max_f32_dpp v209, v208, v208 row_ror:8 row_mask:0xf bank_mask:0xf
  s_nop 1
  v_max_f32_dpp v209, v209, v209 row_ror:4 row_mask:0xf bank_mask:0xf
  v_sub_f32 v209, v208, v209
  v_exp_f32 v209, v209
  s_nop 0
  v_mul_f32 v211, v209, v210
  s_nop 1
  v_add_f32_dpp v211, v211, v211 row_ror:8 row_mask:0xf bank_mask:0xf
  s_nop 1
  v_add_f32_dpp v211, v211, v211 row_ror:4 row_mask:0xf bank_mask:0xf
  v_rcp_f32 v211, v211
  s_nop 0
  v_mul_f32 v209, v209, v211
  s_waitcnt vmcnt(0)
  s_branch L_h1chk
L_h1:
  s_cmp_eq_u32 s6, 0
  s_cbranch_scc0 L_h1slow
  buffer_load_dwordx4 v[184:187], v38, s[48:51], s66 offen offset:0 nt
  buffer_load_dwordx4 v[188:191], v38, s[48:51], s66 offen offset:1024 nt
  buffer_load_dwordx4 v[192:195], v38, s[48:51], s66 offen offset:2048 nt
  buffer_load_dwordx4 v[196:199], v38, s[48:51], s66 offen offset:3072 nt
  s_branch L_h1ld
L_h1slow:
  buffer_load_dwordx4 v[184:187], v38, s[48:51], s66 offen offset:0 sc1
  buffer_load_dwordx4 v[188:191], v38, s[48:51], s66 offen offset:1024 sc1
  buffer_load_dwordx4 v[192:195], v38, s[48:51], s66 offen offset:2048 sc1
  buffer_load_dwordx4 v[196:199], v38, s[48:51], s66 offen offset:3072 sc1
L_h1ld:
  s_mov_b64 exec, -1
  s_waitcnt vmcnt(0)
L_h1chk:
  v_max3_u32 v9, v184, v185, v186
  v_max3_u32 v9, v9, v187, v188
  v_max3_u32 v9, v9, v189, v190
  v_max3_u32 v9, v9, v191, v192
  v_max3_u32 v9, v9, v193, v194
  v_max3_u32 v9, v9, v195, v196
  v_max3_u32 v9, v9, v197, v198
  v_max_u32 v9, v9, v199
  v_cmp_eq_u32 vcc, -1, v9
  s_cbranch_vccz L_h1ok
  s_mov_b64 exec, vcc
  s_add_u32 s65, s65, 1
  s_cmp_gt_u32 s65, 0x8000
  s_cbranch_scc1 L_h1ok
  s_branch L_h1
L_h1ok:
  s_mov_b64 exec, -1
  s_waitcnt lgkmcnt(0)
  v_mfma_f32_16x16x32_bf16 v[72:75], v[120:123], v[184:187], 0
  v_mfma_f32_16x16x32_bf16 v[80:83], v[152:155], v[184:187], 0
  v_mfma_f32_16x16x32_bf16 v[72:75], v[124:127], v[188:191], v[72:75]
  v_mfma_f32_16x16x32_bf16 v[80:83], v[156:159], v[188:191], v[80:83]
  v_mfma_f32_16x16x32_bf16 v[72:75], v[128:131], v[192:195], v[72:75]
  v_mfma_f32_16x16x32_bf16 v[80:83], v[160:163], v[192:195], v[80:83]
  v_mfma_f32_16x16x32_bf16 v[72:75], v[132:135], v[196:199], v[72:75]
  v_mfma_f32_16x16x32_bf16 v[80:83], v[164:167], v[196:199], v[80:83]
  v_mfma_f32_16x16x32_bf16 v[76:79], v[136:139], v[184:187], 0
  v_mfma_f32_16x16x32_bf16 v[84:87], v[168:171], v[184:187], 0
  v_mfma_f32_16x16x32_bf16 v[76:79], v[140:143], v[188:191], v[76:79]
  v_mfma_f32_16x16x32_bf16 v[84:87], v[172:175], v[188:191], v[84:87]
  s_nop 1
  v_mfma_f32_16x16x32_bf16 v[76:79], v[144:147], v[192:195], v[76:79]
  s_nop 0
  v_mul_f32 v72, v209, v72
  v_mul_f32 v73, v209, v73
  v_mul_f32 v74, v209, v74
  v_mul_f32 v75, v209, v75
  v_mfma_f32_16x16x32_bf16 v[84:87], v[176:179], v[192:195], v[84:87]
  v_mul_f32 v80, v209, v80
  v_mul_f32 v81, v209, v81
  v_mul_f32 v82, v209, v82
  v_mul_f32 v83, v209, v83
  v_mfma_f32_16x16x32_bf16 v[76:79], v[148:151], v[196:199], v[76:79]
  v_add_f32_dpp v72, v72, v72 row_ror:8 row_mask:0xf bank_mask:0x3
  v_add_f32_dpp v72, v80, v80 row_ror:8 row_mask:0xf bank_mask:0xc
  v_add_f32_dpp v73, v73, v73 row_ror:8 row_mask:0xf bank_mask:0x3
  v_add_f32_dpp v73, v81, v81 row_ror:8 row_mask:0xf bank_mask:0xc
  v_mfma_f32_16x16x32_bf16 v[84:87], v[180:183], v[196:199], v[84:87]
  v_add_f32_dpp v74, v74, v74 row_ror:8 row_mask:0xf bank_mask:0x3
  v_add_f32_dpp v74, v82, v82 row_ror:8 row_mask:0xf bank_mask:0xc
  v_add_f32_dpp v75, v75, v75 row_ror:8 row_mask:0xf bank_mask:0x3
  v_add_f32_dpp v75, v83, v83 row_ror:8 row_mask:0xf bank_mask:0xc
  s_nop 2
  v_mul_f32 v76, v209, v76
  v_mul_f32 v77, v209, v77
  v_mul_f32 v78, v209, v78
  v_mul_f32 v79, v209, v79
  v_mul_f32 v84, v209, v84
  v_mul_f32 v85, v209, v85
  v_mul_f32 v86, v209, v86
  v_mul_f32 v87, v209, v87
  v_add_f32_dpp v76, v76, v76 row_ror:8 row_mask:0xf bank_mask:0x3
  v_add_f32_dpp v76, v84, v84 row_ror:8 row_mask:0xf bank_mask:0xc
  v_add_f32_dpp v77, v77, v77 row_ror:8 row_mask:0xf bank_mask:0x3
  v_add_f32_dpp v77, v85, v85 row_ror:8 row_mask:0xf bank_mask:0xc
  v_add_f32_dpp v78, v78, v78 row_ror:8 row_mask:0xf bank_mask:0x3
  v_add_f32_dpp v78, v86, v86 row_ror:8 row_mask:0xf bank_mask:0xc
  v_add_f32_dpp v79, v79, v79 row_ror:8 row_mask:0xf bank_mask:0x3
  v_add_f32_dpp v79, v87, v87 row_ror:8 row_mask:0xf bank_mask:0xc
  v_add_f32_dpp v72, v72, v72 row_ror:12 row_mask:0xf bank_mask:0x5
  v_add_f32_dpp v72, v76, v76 row_ror:4 row_mask:0xf bank_mask:0xa
  v_add_f32_dpp v73, v73, v73 row_ror:12 row_mask:0xf bank_mask:0x5
  v_add_f32_dpp v73, v77, v77 row_ror:4 row_mask:0xf bank_mask:0xa
  v_add_f32_dpp v74, v74, v74 row_ror:12 row_mask:0xf bank_mask:0x5
  v_add_f32_dpp v74, v78, v78 row_ror:4 row_mask:0xf bank_mask:0xa
  v_add_f32_dpp v75, v75, v75 row_ror:12 row_mask:0xf bank_mask:0x5
  v_add_f32_dpp v75, v79, v79 row_ror:4 row_mask:0xf bank_mask:0xa
  v_bfi_b32 v72, v8, v4, v72
  v_bfi_b32 v73, v8, v5, v73
  v_bfi_b32 v74, v8, v6, v74
  v_bfi_b32 v75, v8, v7, v75
  buffer_store_dwordx4 v[72:75], v36, s[48:51], 0 offen sc1
  s_lshl_b32 s61, s2, 13
  s_lshl_b32 s62, s3, 10
  s_add_u32 s61, s61, s62
  s_add_u32 s61, s61, 0x400000
  s_mov_b32 s63, 0x0c0c0400
  s_mov_b32 s64, 0x04000c0c
  s_lshl_b32 s62, s3, 2
  s_add_u32 s62, s62, 131072
  v_lshrrev_b32 v11, 1, v3
  v_and_b32 v5, 1, v3
  v_lshl_add_u32 v11, v5, 1, v11
  v_lshl_add_u32 v11, v2, 2, v11
  v_lshl_add_u32 v11, v11, 5, s62
  s_lshl_b32 s62, s2, 7
  s_mov_b32 s65, 0
  v_lshlrev_b32 v9, 5, v1
  v_add_u32 v9, 131072, v9
  v_lshlrev_b32 v10, 1, v1
  s_barrier
L_h2:
  buffer_load_dwordx4 v[56:59], v34, s[48:51], s61 offen sc1
  s_waitcnt vmcnt(0)
  v_perm_b32 v5, v57, v56, s63
  v_perm_b32 v6, v59, v58, s64
  v_or_b32 v5, v5, v6
  v_cmp_ne_u32 vcc, v5, v4
  s_cbranch_vccz L_h2ok
  s_add_u32 s65, s65, 1
  s_cmp_gt_u32 s65, 0x8000
  s_cbranch_scc1 L_h2ok
  s_branch L_h2
L_h2ok:
  v_and_b32 v56, 0xffffff00, v56
  v_and_b32 v57, 0xffffff00, v57
  v_and_b32 v58, 0xffffff00, v58
  v_and_b32 v59, 0xffffff00, v59
  s_nop 0
  v_permlane32_swap_b32 v56, v57
  v_permlane32_swap_b32 v58, v59
  v_add_f32 v56, v56, v57
  v_add_f32 v58, v58, v59
  s_nop 1
  v_permlane16_swap_b32 v56, v58
  v_add_f32 v56, v56, v58
  ds_write_b32 v11, v56
  s_waitcnt lgkmcnt(0)
  s_barrier
  s_cmp_eq_u32 s3, 0
  s_cbranch_scc0 L_fin
  ds_read_b128 v[56:59], v9
  ds_read_b128 v[60:63], v9 offset:16
  s_waitcnt lgkmcnt(0)
  v_add_f32 v56, v56, v60
  v_add_f32 v57, v57, v61
  v_add_f32 v58, v58, v62
  v_add_f32 v59, v59, v63
  v_add_f32 v56, v56, v57
  v_add_f32 v58, v58, v59
  v_add_f32 v56, v56, v58
  v_cvt_pk_bf16_f32 v56, v56, v56
  buffer_store_short v56, v10, s[40:43], s62 offen
L_fin:
L_end:
  s_endpgm
L_slow:
  s_waitcnt vmcnt(0) lgkmcnt(0)
  s_barrier
  s_cmp_eq_u32 s3, 0
  s_cbranch_scc0 L_slow2
  buffer_wbl2 sc1
  s_waitcnt vmcnt(0)
  s_lshl_b32 s64, s53, 7
  s_add_u32 s64, s64, 0x20000
  s_mov_b64 exec, 1
  buffer_store_dwordx2 v[50:51], v48, s[48:51], s64 offen sc1
  s_mov_b64 exec, -1
  s_mov_b32 s64, 0x20000
  s_mov_b32 s65, 0
L_slowchk:
  buffer_load_dwordx2 v[52:53], v48, s[48:51], s64 offen sc1
  s_waitcnt vmcnt(0)
  v_cmp_ne_u64 vcc, v[50:51], v[52:53]
  s_cbranch_vccz L_slowok
  s_add_u32 s65, s65, 1
  s_cmp_gt_u32 s65, 0x8000
  s_cbranch_scc1 L_slowok
  s_branch L_slowchk
L_slowok:
  buffer_inv sc1
  s_waitcnt vmcnt(0)
L_slow2:
  s_barrier
  s_mov_b32 s65, 0
  s_mov_b32 s63, 0xe8b2f51
L_slowg:
  s_add_u32 s64, s11, 0x0
  buffer_load_dwordx4 v[120:123], v34, s[48:51], s64 offen sc1
  s_add_u32 s64, s11, 0x2000
  buffer_load_dwordx4 v[124:127], v34, s[48:51], s64 offen sc1
  s_add_u32 s64, s11, 0x4000
  buffer_load_dwordx4 v[128:131], v34, s[48:51], s64 offen sc1
  s_add_u32 s64, s11, 0x6000
  buffer_load_dwordx4 v[132:135], v34, s[48:51], s64 offen sc1
  s_waitcnt vmcnt(0)
  v_perm_b32 v224, v121, v120, s34
  v_perm_b32 v225, v123, v122, s35
  v_or_b32 v224, v224, v225
  v_sub_u32 v224, v224, v50
  v_mul_lo_u32 v224, v224, s63
  v_mov_b32 v226, v224
  v_perm_b32 v224, v125, v124, s34
  v_perm_b32 v225, v127, v126, s35
  v_or_b32 v224, v224, v225
  v_sub_u32 v224, v224, v50
  v_mul_lo_u32 v224, v224, s63
  v_max_u32 v226, v226, v224
  v_perm_b32 v224, v129, v128, s34
  v_perm_b32 v225, v131, v130, s35
  v_or_b32 v224, v224, v225
  v_sub_u32 v224, v224, v50
  v_mul_lo_u32 v224, v224, s63
  v_max_u32 v226, v226, v224
  v_perm_b32 v224, v133, v132, s34
  v_perm_b32 v225, v135, v134, s35
  v_or_b32 v224, v224, v225
  v_sub_u32 v224, v224, v50
  v_mul_lo_u32 v224, v224, s63
  v_max_u32 v226, v226, v224
  v_cmp_lt_u32 vcc, 15, v226
  s_cbranch_vccz L_slowgok
  buffer_inv sc1
  s_waitcnt vmcnt(0)
  s_add_u32 s65, s65, 1
  s_cmp_gt_u32 s65, 0x8000
  s_cbranch_scc1 L_slowgok
  s_branch L_slowg
L_slowgok:
  v_and_b32 v120, 0xffffff00, v120
  v_and_b32 v121, 0xffffff00, v121
  v_and_b32 v122, 0xffffff00, v122
  v_and_b32 v123, 0xffffff00, v123
  v_and_b32 v124, 0xffffff00, v124
  v_and_b32 v125, 0xffffff00, v125
  v_and_b32 v126, 0xffffff00, v126
  v_and_b32 v127, 0xffffff00, v127
  v_and_b32 v128, 0xffffff00, v128
  v_and_b32 v129, 0xffffff00, v129
  v_and_b32 v130, 0xffffff00, v130
  v_and_b32 v131, 0xffffff00, v131
  v_and_b32 v132, 0xffffff00, v132
  v_and_b32 v133, 0xffffff00, v133
  v_and_b32 v134, 0xffffff00, v134
  v_and_b32 v135, 0xffffff00, v135
  v_add_f32 v120, v120, v124
  v_add_f32 v128, v128, v132
  v_add_f32 v121, v121, v125
  v_add_f32 v129, v129, v133
  v_add_f32 v122, v122, v126
  v_add_f32 v130, v130, v134
  v_add_f32 v123, v123, v127
  v_add_f32 v131, v131, v135
  v_add_f32 v120, v120, v128
  v_add_f32 v121, v121, v129
  v_add_f32 v122, v122, v130
  v_add_f32 v123, v123, v131
  v_cvt_pk_bf16_f32 v120, v120, v121
  v_cvt_pk_bf16_f32 v121, v122, v123
  ds_write_b64 v47, v[120:121]
  s_waitcnt lgkmcnt(0)
  s_barrier
  ds_read_b128 v[184:187], v4
  ds_read_b128 v[188:191], v5
  ds_read_b128 v[192:195], v6
  ds_read_b128 v[196:199], v7
  s_branch L_fast
.section .rodata,"a"
.p2align 6
.amdhsa_kernel standalone__gqa_block_cached__sampling_kernel
  .amdhsa_next_free_vgpr 256
  .amdhsa_next_free_sgpr 102
  .amdhsa_accum_offset 256
  .amdhsa_group_segment_fixed_size 0
  .amdhsa_kernarg_size 64
  .amdhsa_user_sgpr_count 2
  .amdhsa_user_sgpr_kernarg_segment_ptr 1
  .amdhsa_system_sgpr_workgroup_id_x 1
.end_amdhsa_kernel
```
